```python
import torch

def _softmax(x, axis=-1):
    return torch.softmax(x, dim=axis)
def _gelu(x):
    return torch.nn.functional.gelu(x, approximate="tanh")
def _silu(x):
    return torch.nn.functional.silu(x)
def _sigmoid(x):
    return torch.sigmoid(x)
def _layernorm(x, axis=-1, eps=1e-5):
    m = x.mean(dim=axis, keepdim=True)
    v = x.var(dim=axis, keepdim=True, unbiased=False)
    return (x - m) / torch.sqrt(v + eps)
def _scatter_add(tgt, idx, src, axis=0):
    return tgt.clone().index_add_(axis, idx, src)
def _segment_sum(src, seg, n):
    out = torch.zeros((n,) + src.shape[1:], dtype=src.dtype)
    return out.index_add_(0, seg, src)
def _pad(x, pw):
    flat = tuple(v for pair in reversed(pw) for v in pair)
    return torch.nn.functional.pad(x, flat)

kernel_name = 'standalone__instancenorm__sampling'

def setup_inputs():

    _w = (lambda a: (lambda t: t.to(torch.bfloat16) if t.is_floating_point() else t)(torch.as_tensor(a)))
    B, C, H, W = 64, 512, 8, 32
    return {
        "x": _w(abs((lambda *s: torch.randn(*s, dtype=torch.bfloat16) * 0.05)(B, C, H, W))),
        "g": _w((lambda *s: torch.randn(*s, dtype=torch.bfloat16) * 0.05)(C) + 1.0),
        "b": _w((lambda *s: torch.randn(*s, dtype=torch.bfloat16) * 0.4)(C)),
    }

def reference(x, g, b):
    mu = x.mean(axis=(-2, -1), keepdims=True)
    var = ((x - mu) ** 2).mean(axis=(-2, -1), keepdims=True)
    xhat = (x - mu) / torch.sqrt(var + 1e-5)
    return xhat * g.reshape(1, -1, 1, 1) + b.reshape(1, -1, 1, 1)
```

```asm
; @launch grid=(512,1,1) block=(256,1,1) lds=0
.amdgcn_target "amdgcn-amd-amdhsa--gfx950"
.text
.globl standalone__instancenorm__sampling_kernel
.p2align 12
.p2align 8
.type standalone__instancenorm__sampling_kernel,@function
standalone__instancenorm__sampling_kernel:
    s_load_dwordx8 s[4:11], s[0:1], 0
    s_cmpk_ge_u32 s2, 512
    s_cbranch_scc1 L_end
    v_lshrrev_b32 v6, 4, v0
    v_and_b32 v7, 15, v0
    v_and_b32 v8, 12, v6
    v_mad_u32_u24 v6, v8, 3, v6
    s_lshl_b32 s3, s2, 6
    v_add_u32 v6, s3, v6
    v_add_lshl_u32 v1, v6, 8, 9
    v_lshl_or_b32 v1, v7, 4, v1
    v_lshl_add_u32 v4, v7, 2, v6
    v_lshlrev_b32 v4, 23, v4
    v_lshrrev_b32 v4, 22, v4
    v_mov_b32 v2, 0
    v_mov_b32 v3, 0
    v_mov_b32 v5, 0
    s_lshl_b32 s12, -1, 16
    s_movk_i32 s14, 0x3f80
    s_mov_b32 s15, 1.0
    s_or_b32 s13, s14, s15
    s_mov_b32 s16, 0xbb800000
    s_mov_b32 s17, 0x3b27c5ac
    s_waitcnt lgkmcnt(0)
    global_load_short_d16_hi v2, v4, s[6:7]
    global_load_short_d16_hi v3, v4, s[8:9]
    global_load_dwordx4 v[28:31], v1, s[4:5] offset:-4096 nt
    global_load_dwordx4 v[32:35], v1, s[4:5] offset:-3840 nt
    global_load_dwordx4 v[36:39], v1, s[4:5] offset:-2048 nt
    global_load_dwordx4 v[40:43], v1, s[4:5] offset:-1792 nt
    global_load_dwordx4 v[44:47], v1, s[4:5] offset:0 nt
    global_load_dwordx4 v[48:51], v1, s[4:5] offset:256 nt
    global_load_dwordx4 v[52:55], v1, s[4:5] offset:2048 nt
    global_load_dwordx4 v[56:59], v1, s[4:5] offset:2304 nt
    s_waitcnt vmcnt(6)
    v_dot2c_f32_bf16 v5, s13, v28
    v_dot2c_f32_bf16 v5, s13, v29
    v_dot2c_f32_bf16 v5, s13, v30
    v_dot2c_f32_bf16 v5, s13, v31
    v_dot2c_f32_bf16 v5, s13, v32
    v_dot2c_f32_bf16 v5, s13, v33
    v_dot2c_f32_bf16 v5, s13, v34
    v_dot2c_f32_bf16 v5, s13, v35
    s_nop 2
    v_add_f32_dpp v5, v5, v5 row_ror:8 row_mask:0xf bank_mask:0xf
    s_nop 1
    v_add_f32_dpp v5, v5, v5 row_ror:4 row_mask:0xf bank_mask:0xf
    s_nop 1
    v_add_f32_dpp v5, v5, v5 row_ror:2 row_mask:0xf bank_mask:0xf
    s_nop 1
    v_add_f32_dpp v5, v5, v5 row_ror:1 row_mask:0xf bank_mask:0xf
    v_mul_f32 v6, s16, v5
    v_cvt_pk_bf16_f32 v6, v6, v6
    v_and_b32 v6, s12, v6
    v_dot2_f32_bf16 v12, v28, s14, v6
    v_dot2_f32_bf16 v13, v28, s15, v6
    v_dot2_f32_bf16 v14, v29, s14, v6
    v_dot2_f32_bf16 v15, v29, s15, v6
    v_dot2_f32_bf16 v16, v30, s14, v6
    v_dot2_f32_bf16 v17, v30, s15, v6
    v_dot2_f32_bf16 v18, v31, s14, v6
    v_dot2_f32_bf16 v19, v31, s15, v6
    v_dot2_f32_bf16 v20, v32, s14, v6
    v_dot2_f32_bf16 v21, v32, s15, v6
    v_dot2_f32_bf16 v22, v33, s14, v6
    v_dot2_f32_bf16 v23, v33, s15, v6
    v_dot2_f32_bf16 v24, v34, s14, v6
    v_dot2_f32_bf16 v25, v34, s15, v6
    v_dot2_f32_bf16 v26, v35, s14, v6
    v_dot2_f32_bf16 v27, v35, s15, v6
    v_pk_mul_f32 v[6:7], v[12:13], v[12:13]
    v_pk_fma_f32 v[6:7], v[14:15], v[14:15], v[6:7]
    v_pk_fma_f32 v[6:7], v[16:17], v[16:17], v[6:7]
    v_pk_fma_f32 v[6:7], v[18:19], v[18:19], v[6:7]
    v_pk_fma_f32 v[6:7], v[20:21], v[20:21], v[6:7]
    v_pk_fma_f32 v[6:7], v[22:23], v[22:23], v[6:7]
    v_pk_fma_f32 v[6:7], v[24:25], v[24:25], v[6:7]
    v_pk_fma_f32 v[6:7], v[26:27], v[26:27], v[6:7]
    v_add_f32 v6, v6, v7
    v_mul_f32 v2, 0x41800000, v2
    s_nop 0
    v_add_f32_dpp v6, v6, v6 row_ror:8 row_mask:0xf bank_mask:0xf
    s_nop 1
    v_add_f32_dpp v6, v6, v6 row_ror:4 row_mask:0xf bank_mask:0xf
    s_nop 1
    v_add_f32_dpp v6, v6, v6 row_ror:2 row_mask:0xf bank_mask:0xf
    s_nop 1
    v_add_f32_dpp v6, v6, v6 row_ror:1 row_mask:0xf bank_mask:0xf
    v_add_f32 v6, s17, v6
    v_rsq_f32 v6, v6
    v_mov_b32 v5, 0
    v_mov_b32_dpp v10, v3 row_newbcast:0 row_mask:0xf bank_mask:0xf
    v_mul_f32_dpp v8, v2, v6 row_newbcast:0 row_mask:0xf bank_mask:0xf
    v_pk_fma_f32 v[12:13], v[12:13], v[8:9], v[10:11] op_sel_hi:[1,0,0]
    v_pk_fma_f32 v[14:15], v[14:15], v[8:9], v[10:11] op_sel_hi:[1,0,0]
    v_pk_fma_f32 v[16:17], v[16:17], v[8:9], v[10:11] op_sel_hi:[1,0,0]
    v_pk_fma_f32 v[18:19], v[18:19], v[8:9], v[10:11] op_sel_hi:[1,0,0]
    v_pk_fma_f32 v[20:21], v[20:21], v[8:9], v[10:11] op_sel_hi:[1,0,0]
    v_pk_fma_f32 v[22:23], v[22:23], v[8:9], v[10:11] op_sel_hi:[1,0,0]
    v_pk_fma_f32 v[24:25], v[24:25], v[8:9], v[10:11] op_sel_hi:[1,0,0]
    v_pk_fma_f32 v[26:27], v[26:27], v[8:9], v[10:11] op_sel_hi:[1,0,0]
    v_cvt_pk_bf16_f32 v28, v12, v13
    v_cvt_pk_bf16_f32 v29, v14, v15
    v_cvt_pk_bf16_f32 v30, v16, v17
    v_cvt_pk_bf16_f32 v31, v18, v19
    v_cvt_pk_bf16_f32 v32, v20, v21
    v_cvt_pk_bf16_f32 v33, v22, v23
    v_cvt_pk_bf16_f32 v34, v24, v25
    v_cvt_pk_bf16_f32 v35, v26, v27
    s_waitcnt vmcnt(4)
    v_dot2c_f32_bf16 v5, s13, v36
    v_dot2c_f32_bf16 v5, s13, v37
    v_dot2c_f32_bf16 v5, s13, v38
    v_dot2c_f32_bf16 v5, s13, v39
    v_dot2c_f32_bf16 v5, s13, v40
    v_dot2c_f32_bf16 v5, s13, v41
    v_dot2c_f32_bf16 v5, s13, v42
    v_dot2c_f32_bf16 v5, s13, v43
    s_nop 2
    v_add_f32_dpp v5, v5, v5 row_ror:8 row_mask:0xf bank_mask:0xf
    s_nop 1
    v_add_f32_dpp v5, v5, v5 row_ror:4 row_mask:0xf bank_mask:0xf
    s_nop 1
    v_add_f32_dpp v5, v5, v5 row_ror:2 row_mask:0xf bank_mask:0xf
    s_nop 1
    v_add_f32_dpp v5, v5, v5 row_ror:1 row_mask:0xf bank_mask:0xf
    v_mul_f32 v6, s16, v5
    v_cvt_pk_bf16_f32 v6, v6, v6
    v_and_b32 v6, s12, v6
    v_dot2_f32_bf16 v12, v36, s14, v6
    v_dot2_f32_bf16 v13, v36, s15, v6
    v_dot2_f32_bf16 v14, v37, s14, v6
    v_dot2_f32_bf16 v15, v37, s15, v6
    v_dot2_f32_bf16 v16, v38, s14, v6
    v_dot2_f32_bf16 v17, v38, s15, v6
    v_dot2_f32_bf16 v18, v39, s14, v6
    v_dot2_f32_bf16 v19, v39, s15, v6
    v_dot2_f32_bf16 v20, v40, s14, v6
    v_dot2_f32_bf16 v21, v40, s15, v6
    v_dot2_f32_bf16 v22, v41, s14, v6
    v_dot2_f32_bf16 v23, v41, s15, v6
    v_dot2_f32_bf16 v24, v42, s14, v6
    v_dot2_f32_bf16 v25, v42, s15, v6
    v_dot2_f32_bf16 v26, v43, s14, v6
    v_dot2_f32_bf16 v27, v43, s15, v6
    v_pk_mul_f32 v[6:7], v[12:13], v[12:13]
    v_pk_fma_f32 v[6:7], v[14:15], v[14:15], v[6:7]
    v_pk_fma_f32 v[6:7], v[16:17], v[16:17], v[6:7]
    v_pk_fma_f32 v[6:7], v[18:19], v[18:19], v[6:7]
    v_pk_fma_f32 v[6:7], v[20:21], v[20:21], v[6:7]
    v_pk_fma_f32 v[6:7], v[22:23], v[22:23], v[6:7]
    v_pk_fma_f32 v[6:7], v[24:25], v[24:25], v[6:7]
    v_pk_fma_f32 v[6:7], v[26:27], v[26:27], v[6:7]
    v_add_f32 v6, v6, v7
    s_nop 1
    v_add_f32_dpp v6, v6, v6 row_ror:8 row_mask:0xf bank_mask:0xf
    s_nop 1
    v_add_f32_dpp v6, v6, v6 row_ror:4 row_mask:0xf bank_mask:0xf
    s_nop 1
    v_add_f32_dpp v6, v6, v6 row_ror:2 row_mask:0xf bank_mask:0xf
    s_nop 1
    v_add_f32_dpp v6, v6, v6 row_ror:1 row_mask:0xf bank_mask:0xf
    v_add_f32 v6, s17, v6
    v_rsq_f32 v6, v6
    v_mov_b32 v5, 0
    v_mov_b32_dpp v10, v3 row_newbcast:1 row_mask:0xf bank_mask:0xf
    v_mul_f32_dpp v8, v2, v6 row_newbcast:1 row_mask:0xf bank_mask:0xf
    v_pk_fma_f32 v[12:13], v[12:13], v[8:9], v[10:11] op_sel_hi:[1,0,0]
    v_pk_fma_f32 v[14:15], v[14:15], v[8:9], v[10:11] op_sel_hi:[1,0,0]
    v_pk_fma_f32 v[16:17], v[16:17], v[8:9], v[10:11] op_sel_hi:[1,0,0]
    v_pk_fma_f32 v[18:19], v[18:19], v[8:9], v[10:11] op_sel_hi:[1,0,0]
    v_pk_fma_f32 v[20:21], v[20:21], v[8:9], v[10:11] op_sel_hi:[1,0,0]
    v_pk_fma_f32 v[22:23], v[22:23], v[8:9], v[10:11] op_sel_hi:[1,0,0]
    v_pk_fma_f32 v[24:25], v[24:25], v[8:9], v[10:11] op_sel_hi:[1,0,0]
    v_pk_fma_f32 v[26:27], v[26:27], v[8:9], v[10:11] op_sel_hi:[1,0,0]
    v_cvt_pk_bf16_f32 v36, v12, v13
    v_cvt_pk_bf16_f32 v37, v14, v15
    v_cvt_pk_bf16_f32 v38, v16, v17
    v_cvt_pk_bf16_f32 v39, v18, v19
    v_cvt_pk_bf16_f32 v40, v20, v21
    v_cvt_pk_bf16_f32 v41, v22, v23
    v_cvt_pk_bf16_f32 v42, v24, v25
    v_cvt_pk_bf16_f32 v43, v26, v27
    s_waitcnt vmcnt(2)
    v_dot2c_f32_bf16 v5, s13, v44
    v_dot2c_f32_bf16 v5, s13, v45
    v_dot2c_f32_bf16 v5, s13, v46
    v_dot2c_f32_bf16 v5, s13, v47
    v_dot2c_f32_bf16 v5, s13, v48
    v_dot2c_f32_bf16 v5, s13, v49
    v_dot2c_f32_bf16 v5, s13, v50
    v_dot2c_f32_bf16 v5, s13, v51
    s_nop 2
    v_add_f32_dpp v5, v5, v5 row_ror:8 row_mask:0xf bank_mask:0xf
    s_nop 1
    v_add_f32_dpp v5, v5, v5 row_ror:4 row_mask:0xf bank_mask:0xf
    s_nop 1
    v_add_f32_dpp v5, v5, v5 row_ror:2 row_mask:0xf bank_mask:0xf
    s_nop 1
    v_add_f32_dpp v5, v5, v5 row_ror:1 row_mask:0xf bank_mask:0xf
    v_mul_f32 v6, s16, v5
    v_cvt_pk_bf16_f32 v6, v6, v6
    v_and_b32 v6, s12, v6
    v_dot2_f32_bf16 v12, v44, s14, v6
    v_dot2_f32_bf16 v13, v44, s15, v6
    v_dot2_f32_bf16 v14, v45, s14, v6
    v_dot2_f32_bf16 v15, v45, s15, v6
    v_dot2_f32_bf16 v16, v46, s14, v6
    v_dot2_f32_bf16 v17, v46, s15, v6
    v_dot2_f32_bf16 v18, v47, s14, v6
    v_dot2_f32_bf16 v19, v47, s15, v6
    v_dot2_f32_bf16 v20, v48, s14, v6
    v_dot2_f32_bf16 v21, v48, s15, v6
    v_dot2_f32_bf16 v22, v49, s14, v6
    v_dot2_f32_bf16 v23, v49, s15, v6
    v_dot2_f32_bf16 v24, v50, s14, v6
    v_dot2_f32_bf16 v25, v50, s15, v6
    v_dot2_f32_bf16 v26, v51, s14, v6
    v_dot2_f32_bf16 v27, v51, s15, v6
    v_pk_mul_f32 v[6:7], v[12:13], v[12:13]
    v_pk_fma_f32 v[6:7], v[14:15], v[14:15], v[6:7]
    v_pk_fma_f32 v[6:7], v[16:17], v[16:17], v[6:7]
    v_pk_fma_f32 v[6:7], v[18:19], v[18:19], v[6:7]
    v_pk_fma_f32 v[6:7], v[20:21], v[20:21], v[6:7]
    v_pk_fma_f32 v[6:7], v[22:23], v[22:23], v[6:7]
    v_pk_fma_f32 v[6:7], v[24:25], v[24:25], v[6:7]
    v_pk_fma_f32 v[6:7], v[26:27], v[26:27], v[6:7]
    v_add_f32 v6, v6, v7
    s_nop 1
    v_add_f32_dpp v6, v6, v6 row_ror:8 row_mask:0xf bank_mask:0xf
    s_nop 1
    v_add_f32_dpp v6, v6, v6 row_ror:4 row_mask:0xf bank_mask:0xf
    s_nop 1
    v_add_f32_dpp v6, v6, v6 row_ror:2 row_mask:0xf bank_mask:0xf
    s_nop 1
    v_add_f32_dpp v6, v6, v6 row_ror:1 row_mask:0xf bank_mask:0xf
    v_add_f32 v6, s17, v6
    v_rsq_f32 v6, v6
    v_mov_b32 v5, 0
    v_mov_b32_dpp v10, v3 row_newbcast:2 row_mask:0xf bank_mask:0xf
    v_mul_f32_dpp v8, v2, v6 row_newbcast:2 row_mask:0xf bank_mask:0xf
    v_pk_fma_f32 v[12:13], v[12:13], v[8:9], v[10:11] op_sel_hi:[1,0,0]
    v_pk_fma_f32 v[14:15], v[14:15], v[8:9], v[10:11] op_sel_hi:[1,0,0]
    v_pk_fma_f32 v[16:17], v[16:17], v[8:9], v[10:11] op_sel_hi:[1,0,0]
    v_pk_fma_f32 v[18:19], v[18:19], v[8:9], v[10:11] op_sel_hi:[1,0,0]
    v_pk_fma_f32 v[20:21], v[20:21], v[8:9], v[10:11] op_sel_hi:[1,0,0]
    v_pk_fma_f32 v[22:23], v[22:23], v[8:9], v[10:11] op_sel_hi:[1,0,0]
    v_pk_fma_f32 v[24:25], v[24:25], v[8:9], v[10:11] op_sel_hi:[1,0,0]
    v_pk_fma_f32 v[26:27], v[26:27], v[8:9], v[10:11] op_sel_hi:[1,0,0]
    v_cvt_pk_bf16_f32 v44, v12, v13
    v_cvt_pk_bf16_f32 v45, v14, v15
    v_cvt_pk_bf16_f32 v46, v16, v17
    v_cvt_pk_bf16_f32 v47, v18, v19
    v_cvt_pk_bf16_f32 v48, v20, v21
    v_cvt_pk_bf16_f32 v49, v22, v23
    v_cvt_pk_bf16_f32 v50, v24, v25
    v_cvt_pk_bf16_f32 v51, v26, v27
    s_waitcnt vmcnt(0)
    global_store_dwordx4 v1, v[28:31], s[10:11] offset:-4096 nt
    global_store_dwordx4 v1, v[32:35], s[10:11] offset:-3840 nt
    global_store_dwordx4 v1, v[36:39], s[10:11] offset:-2048 nt
    global_store_dwordx4 v1, v[40:43], s[10:11] offset:-1792 nt
    global_store_dwordx4 v1, v[44:47], s[10:11] offset:0 nt
    global_store_dwordx4 v1, v[48:51], s[10:11] offset:256 nt
    v_dot2c_f32_bf16 v5, s13, v52
    v_dot2c_f32_bf16 v5, s13, v53
    v_dot2c_f32_bf16 v5, s13, v54
    v_dot2c_f32_bf16 v5, s13, v55
    v_dot2c_f32_bf16 v5, s13, v56
    v_dot2c_f32_bf16 v5, s13, v57
    v_dot2c_f32_bf16 v5, s13, v58
    v_dot2c_f32_bf16 v5, s13, v59
    s_nop 2
    v_add_f32_dpp v5, v5, v5 row_ror:8 row_mask:0xf bank_mask:0xf
    s_nop 1
    v_add_f32_dpp v5, v5, v5 row_ror:4 row_mask:0xf bank_mask:0xf
    s_nop 1
    v_add_f32_dpp v5, v5, v5 row_ror:2 row_mask:0xf bank_mask:0xf
    s_nop 1
    v_add_f32_dpp v5, v5, v5 row_ror:1 row_mask:0xf bank_mask:0xf
    v_mul_f32 v6, s16, v5
    v_cvt_pk_bf16_f32 v6, v6, v6
    v_and_b32 v6, s12, v6
    v_dot2_f32_bf16 v12, v52, s14, v6
    v_dot2_f32_bf16 v13, v52, s15, v6
    v_dot2_f32_bf16 v14, v53, s14, v6
    v_dot2_f32_bf16 v15, v53, s15, v6
    v_dot2_f32_bf16 v16, v54, s14, v6
    v_dot2_f32_bf16 v17, v54, s15, v6
    v_dot2_f32_bf16 v18, v55, s14, v6
    v_dot2_f32_bf16 v19, v55, s15, v6
    v_dot2_f32_bf16 v20, v56, s14, v6
    v_dot2_f32_bf16 v21, v56, s15, v6
    v_dot2_f32_bf16 v22, v57, s14, v6
    v_dot2_f32_bf16 v23, v57, s15, v6
    v_dot2_f32_bf16 v24, v58, s14, v6
    v_dot2_f32_bf16 v25, v58, s15, v6
    v_dot2_f32_bf16 v26, v59, s14, v6
    v_dot2_f32_bf16 v27, v59, s15, v6
    v_pk_mul_f32 v[6:7], v[12:13], v[12:13]
    v_pk_fma_f32 v[6:7], v[14:15], v[14:15], v[6:7]
    v_pk_fma_f32 v[6:7], v[16:17], v[16:17], v[6:7]
    v_pk_fma_f32 v[6:7], v[18:19], v[18:19], v[6:7]
    v_pk_fma_f32 v[6:7], v[20:21], v[20:21], v[6:7]
    v_pk_fma_f32 v[6:7], v[22:23], v[22:23], v[6:7]
    v_pk_fma_f32 v[6:7], v[24:25], v[24:25], v[6:7]
    v_pk_fma_f32 v[6:7], v[26:27], v[26:27], v[6:7]
    v_add_f32 v6, v6, v7
    s_nop 1
    v_add_f32_dpp v6, v6, v6 row_ror:8 row_mask:0xf bank_mask:0xf
    s_nop 1
    v_add_f32_dpp v6, v6, v6 row_ror:4 row_mask:0xf bank_mask:0xf
    s_nop 1
    v_add_f32_dpp v6, v6, v6 row_ror:2 row_mask:0xf bank_mask:0xf
    s_nop 1
    v_add_f32_dpp v6, v6, v6 row_ror:1 row_mask:0xf bank_mask:0xf
    v_add_f32 v6, s17, v6
    v_rsq_f32 v6, v6
    s_nop 0
    v_mov_b32_dpp v10, v3 row_newbcast:3 row_mask:0xf bank_mask:0xf
    v_mul_f32_dpp v8, v2, v6 row_newbcast:3 row_mask:0xf bank_mask:0xf
    v_pk_fma_f32 v[12:13], v[12:13], v[8:9], v[10:11] op_sel_hi:[1,0,0]
    v_pk_fma_f32 v[14:15], v[14:15], v[8:9], v[10:11] op_sel_hi:[1,0,0]
    v_pk_fma_f32 v[16:17], v[16:17], v[8:9], v[10:11] op_sel_hi:[1,0,0]
    v_pk_fma_f32 v[18:19], v[18:19], v[8:9], v[10:11] op_sel_hi:[1,0,0]
    v_cvt_pk_bf16_f32 v52, v12, v13
    v_cvt_pk_bf16_f32 v53, v14, v15
    v_cvt_pk_bf16_f32 v54, v16, v17
    v_cvt_pk_bf16_f32 v55, v18, v19
    global_store_dwordx4 v1, v[52:55], s[10:11] offset:2048 nt
    v_pk_fma_f32 v[20:21], v[20:21], v[8:9], v[10:11] op_sel_hi:[1,0,0]
    v_pk_fma_f32 v[22:23], v[22:23], v[8:9], v[10:11] op_sel_hi:[1,0,0]
    v_pk_fma_f32 v[24:25], v[24:25], v[8:9], v[10:11] op_sel_hi:[1,0,0]
    v_pk_fma_f32 v[26:27], v[26:27], v[8:9], v[10:11] op_sel_hi:[1,0,0]
    v_cvt_pk_bf16_f32 v56, v20, v21
    v_cvt_pk_bf16_f32 v57, v22, v23
    v_cvt_pk_bf16_f32 v58, v24, v25
    v_cvt_pk_bf16_f32 v59, v26, v27
    global_store_dwordx4 v1, v[56:59], s[10:11] offset:2304 nt
L_end:
    s_endpgm
.section .rodata,"a"
.p2align 6
.amdhsa_kernel standalone__instancenorm__sampling_kernel
  .amdhsa_next_free_vgpr 60
  .amdhsa_next_free_sgpr 24
  .amdhsa_accum_offset 60
  .amdhsa_group_segment_fixed_size 0
  .amdhsa_kernarg_size 48
  .amdhsa_user_sgpr_count 2
  .amdhsa_user_sgpr_kernarg_segment_ptr 1
  .amdhsa_system_sgpr_workgroup_id_x 1
  .amdhsa_float_denorm_mode_32 3
.end_amdhsa_kernel
```
